```python
import torch

def _softmax(x, axis=-1):
    return torch.softmax(x, dim=axis)

def _gelu(x):
    return torch.nn.functional.gelu(x, approximate='tanh')

def _silu(x):
    return torch.nn.functional.silu(x)

def _sigmoid(x):
    return torch.sigmoid(x)

def _layernorm(x, axis=-1, eps=1e-05):
    m = x.mean(dim=axis, keepdim=True)
    v = x.var(dim=axis, keepdim=True, unbiased=False)
    return (x - m) / torch.sqrt(v + eps)

def _scatter_add(tgt, idx, src, axis=0):
    return tgt.clone().index_add_(axis, idx, src)

def _segment_sum(src, seg, n):
    out = torch.zeros((n,) + src.shape[1:], dtype=src.dtype)
    return out.index_add_(0, seg, src)

def _pad(x, pw):
    flat = tuple((v for pair in reversed(pw) for v in pair))
    return torch.nn.functional.pad(x, flat)
kernel_name = 'standalone__tree_speculative_verify_tree_attention_over_candidate_token_tree__sampling'

def setup_inputs():

    _w = lambda a: (lambda t: t.to(torch.bfloat16) if t.is_floating_point() else t)(torch.as_tensor(a))
    B, Hq, Hkv, T, C, D = (8, 32, 16, 16, 8192, 128)
    tree_mask = torch.zeros((B, T, T), dtype=float)
    for b in range(B):
        parent = torch.zeros(T, dtype=torch.int64)
        for i in range(1, T):
            parent[i] = int(torch.randint(0, i, (1,)).item())
        for i in range(T):
            j = i
            tree_mask[b, i, j] = 1.0
            while j > 0:
                j = parent[j]
                tree_mask[b, i, j] = 1.0
    return {'q': _w((lambda *s: torch.randn(*s, dtype=torch.bfloat16) * 0.8)(B, Hq, T, D)), 'k_cache': _w((lambda *s: torch.randn(*s, dtype=torch.bfloat16) * 0.8)(B, Hkv, C, D)), 'v_cache': _w((lambda *s: torch.randn(*s, dtype=torch.bfloat16) * 0.05)(B, Hkv, C, D)), 'k_tree': _w((lambda *s: torch.randn(*s, dtype=torch.bfloat16) * 0.8)(B, Hkv, T, D)), 'v_tree': _w((lambda *s: torch.randn(*s, dtype=torch.bfloat16) * 0.05)(B, Hkv, T, D)), 'tree_mask': _w(tree_mask)}

def reference(q, k_cache, v_cache, k_tree, v_tree, tree_mask):
    B, Hq, T, D = q.shape
    Hkv, C = (k_cache.shape[1], k_cache.shape[2])
    rep = Hq // Hkv
    kc = (lambda x, n, axis: torch.repeat_interleave(x, n, dim=axis))(k_cache, rep, axis=1)
    vc = (lambda x, n, axis: torch.repeat_interleave(x, n, dim=axis))(v_cache, rep, axis=1)
    kt = (lambda x, n, axis: torch.repeat_interleave(x, n, dim=axis))(k_tree, rep, axis=1)
    vt = (lambda x, n, axis: torch.repeat_interleave(x, n, dim=axis))(v_tree, rep, axis=1)
    k = torch.concatenate([kc, kt], axis=2)
    v = torch.concatenate([vc, vt], axis=2)
    scale = D ** (-0.5)
    scores = torch.einsum('bhqd,bhkd->bhqk', q, k) * scale
    ctx_mask = torch.ones((B, 1, T, C), dtype=scores.dtype)
    tm = tree_mask[:, None, :, :].clone()
    full_mask = torch.concatenate([ctx_mask, tm], axis=-1)
    scores = scores + (1.0 - full_mask) * -1000000000.0
    p = _softmax(scores, axis=-1)
    return torch.einsum('bhqk,bhkd->bhqd', p, v)
```

```asm
; @launch grid=(256,1,1) block=(256,1,1) lds=154880
.amdgcn_target "amdgcn-amd-amdhsa--gfx950"
.text
.globl standalone__tree_speculative_verify_tree_attention_over_candidate_token_tree__sampling_kernel
.p2align 12
.fill 832, 4, 0xbf810000
.p2align 8
.type standalone__tree_speculative_verify_tree_attention_over_candidate_token_tree__sampling_kernel,@function
standalone__tree_speculative_verify_tree_attention_over_candidate_token_tree__sampling_kernel:
    s_cmp_ge_u32 s2, 256
    s_cbranch_scc1 L_done
    s_load_dwordx16 s[8:23], s[0:1], 8
    s_load_dwordx2 s[4:5], s[0:1], 0
    v_lshrrev_b32 v11, 6, v0
    v_and_b32 v1, 63, v0
    v_readfirstlane_b32 s60, v11
    s_lshr_b32 s68, s2, 4
    s_lshl_b32 s68, s68, 3
    s_and_b32 s66, s2, 7
    s_or_b32 s66, s66, s68
    s_bfe_u32 s67, s2, 0x10003
    v_lshrrev_b32 v11, 4, v1
    v_and_b32 v12, 15, v1
    s_lshl_b32 s61, s60, 15
    v_xor_b32 v13, v11, v12
    v_lshlrev_b32 v14, 8, v11
    v_lshl_add_u32 v2, v13, 4, v14
    v_xor_b32 v3, 64, v2
    v_xor_b32 v4, 128, v2
    v_xor_b32 v5, 192, v2
    s_lshl_b32 s62, s67, 2
    s_add_u32 s62, s62, s60
    s_lshl_b32 s62, s62, 12
    s_add_u32 s63, s62, 65536
    s_lshl_b32 s68, s66, 21
    s_mov_b32 s26, 2097152
    s_mov_b32 s27, 0x20000
    s_waitcnt lgkmcnt(0)
    s_add_u32 s24, s8, s68
    s_addc_u32 s25, s9, 0
    s_and_b32 s25, s25, 0xffff
    s_add_u32 m0, s61, 0
    s_nop 0
    buffer_load_dwordx4 v2, s[24:27], s62 offen offset:0 nt lds
    s_add_u32 m0, s61, 4096
    s_nop 0
    buffer_load_dwordx4 v2, s[24:27], s63 offen offset:0 nt lds
    s_add_u32 m0, s61, 0
    s_nop 0
    buffer_load_dwordx4 v3, s[24:27], s62 offen offset:1024 nt lds
    s_add_u32 m0, s61, 4096
    s_nop 0
    buffer_load_dwordx4 v3, s[24:27], s63 offen offset:1024 nt lds
    s_add_u32 m0, s61, 0
    s_nop 0
    buffer_load_dwordx4 v4, s[24:27], s62 offen offset:2048 nt lds
    s_getpc_b64 s[6:7]
L_u1:
    s_lshr_b32 s70, s2, 3
    s_lshl_b32 s70, s70, 2
    s_add_u32 s70, s70, s60
    s_lshl_b32 s70, s70, 7
    s_min_u32 s70, s70, L_code_end-standalone__tree_speculative_verify_tree_attention_over_candidate_token_tree__sampling_kernel-4
    s_sub_u32 s6, s6, L_u1-standalone__tree_speculative_verify_tree_attention_over_candidate_token_tree__sampling_kernel
    s_subb_u32 s7, s7, 0
    s_add_u32 s6, s6, s70
    s_addc_u32 s7, s7, 0
    v_mov_b32 v232, s6
    v_mov_b32 v233, s7
    global_load_dword v245, v[232:233], off
    s_lshl_b32 s70, s60, 7
    s_and_b32 s70, s70, 128
    v_xor_b32 v237, s70, v2
    v_xor_b32 v238, s70, v3
    s_lshl_b32 s69, s66, 13
    s_lshl_b32 s71, s60, 11
    s_add_u32 m0, s71, 131072
    s_add_u32 s32, s4, s69
    s_addc_u32 s33, s5, 0
    s_and_b32 s33, s33, 0xffff
    s_mov_b32 s34, 8192
    s_mov_b32 s35, 0x20000
    buffer_load_dwordx4 v237, s[32:35], s71 offen lds
    buffer_load_dwordx4 v238, s[32:35], s71 offen offset:1024 lds
    v_lshlrev_b32 v13, 2, v11
    v_xor_b32 v13, v13, v12
    v_lshl_add_u32 v6, v13, 4, v14
    s_cmp_eq_u32 s62, 28672
    s_cbranch_scc1 L_tree_ld
L_tree_ld_ret:
    v_and_b32 v11, 31, v1
    v_lshrrev_b32 v12, 5, v1
    s_and_b32 s70, s2, 7
    s_mul_i32 s70, s70, 4352
    s_add_u32 s70, s70, 4194304
    s_add_u32 s28, s22, s70
    s_addc_u32 s29, s23, 0
    s_and_b32 s29, s29, 0xffff
    s_mov_b32 s30, 128
    s_mov_b32 s31, 0x20000
    s_lshr_b32 s70, s2, 3
    s_lshl_b32 s70, s70, 2
    v_lshl_add_u32 v244, v0, 7, s70
    v_mov_b32 v241, 0
    buffer_store_dword v241, v244, s[28:31], 0 offen
    v_lshlrev_b32 v243, 2, v11
    v_and_b32 v13, 15, v11
    v_xor_b32 v13, v13, v12
    v_lshlrev_b32 v14, 8, v11
    v_lshl_add_u32 v14, v13, 4, v14
    v_xor_b32 v16, 0, v14
    v_xor_b32 v17, 32, v14
    v_xor_b32 v18, 64, v14
    v_xor_b32 v19, 96, v14
    v_xor_b32 v20, 128, v14
    v_xor_b32 v21, 160, v14
    v_xor_b32 v22, 192, v14
    v_xor_b32 v23, 224, v14
    v_add_u32 v64, 131072, v16
    v_add_u32 v65, 131072, v17
    v_add_u32 v66, 131072, v18
    v_add_u32 v67, 131072, v19
    v_add_u32 v68, 131072, v20
    v_add_u32 v69, 131072, v21
    v_add_u32 v70, 131072, v22
    v_add_u32 v71, 131072, v23
    v_add_u32 v16, s61, v16
    v_add_u32 v17, s61, v17
    v_add_u32 v18, s61, v18
    v_add_u32 v19, s61, v19
    v_add_u32 v20, s61, v20
    v_add_u32 v21, s61, v21
    v_add_u32 v22, s61, v22
    v_add_u32 v23, s61, v23
    v_bfe_u32 v13, v1, 2, 2
    v_lshl_add_u32 v14, v12, 2, v13
    v_lshlrev_b32 v14, 8, v14
    v_xor_b32 v13, s60, v13
    v_lshl_add_u32 v14, v13, 6, v14
    v_bfe_u32 v15, v1, 4, 1
    v_lshl_add_u32 v14, v15, 5, v14
    v_and_b32 v15, 3, v1
    v_lshl_add_u32 v24, v15, 3, v14
    v_add_u32 v25, 0x10000, v24
    v_lshlrev_b32 v26, 4, v1
    v_add_u32 v26, 131072, v26
    v_add_u32 v27, s71, v26
    v_mov_b32 v157, 0xf149f2ca
    v_mov_b32 v242, 0x7fffffff
    s_mov_b32 s73, 0x3f803f80
    s_mov_b32 s65, 0x3e0293ee
    s_getreg_b32 s75, hwreg(HW_REG_XCC_ID, 0, 4)
    s_add_u32 s92, s61, 0
    s_add_u32 s93, s61, 4096
    s_add_u32 s94, s61, 8192
    s_add_u32 s95, s61, 12288
    s_mov_b32 s74, 0
    s_mov_b32 s3, 0
    v_mov_b32 v240, 0xf149f2ca
    v_mov_b32 v9, 0xf149f2ca
    v_mov_b32 v8, 0
    v_mov_b32 v7, v2
    s_lshl_b32 s70, s66, 15
    s_add_u32 s52, s22, s70
    s_addc_u32 s53, s23, 0
    s_and_b32 s53, s53, 0xffff
    s_mov_b32 s54, 32768
    s_mov_b32 s55, 0x20000
    s_add_u32 s48, s18, s69
    s_addc_u32 s49, s19, 0
    s_and_b32 s49, s49, 0xffff
    s_mov_b32 s50, 8192
    s_mov_b32 s51, 0x20000
    s_mul_i32 s76, s60, 2432
    s_add_u32 s78, s76, 128
    s_add_u32 s70, s76, 384
    v_mov_b32 v29, 154624
    v_lshlrev_b32 v234, 3, v11
    v_lshl_add_u32 v31, v1, 4, s70
    v_min_u32 v13, 2, v1
    v_lshlrev_b32 v13, 7, v13
    s_lshl_b32 s77, s60, 6
    s_add_u32 s72, s67, 1
    buffer_load_dword v28, v13, s[52:55], s76 offen sc1
    s_bitcmp1_b32 3, s67
    s_cselect_b32 s97, 28, 63
    s_add_u32 s58, s77, 4096
    v_mul_u32_u24 v30, 80, v11
    v_lshl_add_u32 v30, v12, 3, v30
    v_add_u32 v30, s61, v30
    v_and_b32 v239, 3, v1
    v_lshlrev_b32 v239, 4, v239
    v_lshrrev_b32 v14, 2, v1
    v_lshl_add_u32 v15, v14, 8, v239
    v_mul_u32_u24 v14, 80, v14
    v_add3_u32 v239, v239, v14, s61
    s_mov_b32 s100, 32
    s_mov_b32 s6, 0x9150915
    s_mov_b32 s7, 0xc180c18
    s_lshl_b32 s70, s75, 3
    s_lshr_b64 s[6:7], s[6:7], s70
    s_lshl_b32 s98, s6, 26
    s_lshr_b32 s101, s2, 4
    s_lshl_b32 s101, s101, 28
    s_mov_b32 s79, 0
    v_mov_b64 v[200:201], 0
    v_mov_b64 v[202:203], 0
    v_mov_b64 v[204:205], 0
    v_mov_b64 v[206:207], 0
    v_mov_b64 v[208:209], 0
    v_mov_b64 v[210:211], 0
    v_mov_b64 v[212:213], 0
    v_mov_b64 v[214:215], 0
    s_movk_i32 s59, 0x4000
    s_cmp_eq_u32 s62, 28672
    s_cbranch_scc1 L_tree
    s_mov_b32 m0, s93
    s_waitcnt vmcnt(9)
    buffer_load_dwordx4 v4, s[24:27], s63 offen offset:2048 nt lds
    s_mov_b32 m0, s92
    s_waitcnt vmcnt(9)
    buffer_load_dwordx4 v5, s[24:27], s62 offen offset:3072 nt lds
    s_mov_b32 m0, s93
    s_waitcnt vmcnt(9)
    buffer_load_dwordx4 v5, s[24:27], s63 offen offset:3072 nt lds
    s_add_u32 s62, s62, 32768
    s_add_u32 s63, s63, 32768
    s_mov_b32 m0, s94
    s_waitcnt vmcnt(9)
    buffer_load_dwordx4 v2, s[24:27], s62 offen offset:0 nt lds
    s_mov_b32 m0, s95
    s_waitcnt vmcnt(9)
    buffer_load_dwordx4 v2, s[24:27], s63 offen offset:0 nt lds
    s_mov_b32 m0, s94
    s_waitcnt vmcnt(4)
    buffer_load_dwordx4 v3, s[24:27], s62 offen offset:1024 nt lds
    s_barrier
    ds_read_b128 v[32:35], v64
    ds_read_b128 v[36:39], v65
    ds_read_b128 v[40:43], v66
    ds_read_b128 v[44:47], v67
    ds_read_b128 v[48:51], v68
    ds_read_b128 v[52:55], v69
    ds_read_b128 v[56:59], v70
    ds_read_b128 v[60:63], v71
    s_mov_b32 m0, s95
    s_waitcnt vmcnt(4)
    buffer_load_dwordx4 v3, s[24:27], s63 offen offset:1024 nt lds
    s_mov_b32 m0, s94
    s_waitcnt vmcnt(4)
    buffer_load_dwordx4 v4, s[24:27], s62 offen offset:2048 nt lds
    s_mov_b32 m0, s95
    s_waitcnt vmcnt(4)
    buffer_load_dwordx4 v4, s[24:27], s63 offen offset:2048 nt lds
    s_mov_b32 m0, s94
    s_waitcnt vmcnt(4)
    buffer_load_dwordx4 v5, s[24:27], s62 offen offset:3072 nt lds
    s_mov_b32 m0, s95
    s_waitcnt vmcnt(4)
    buffer_load_dwordx4 v5, s[24:27], s63 offen offset:3072 nt lds
L_main:
    s_waitcnt lgkmcnt(0)
    s_mov_b32 s64, 0
    s_mov_b32 s96, 0
    s_branch L_kloop
L_tree_ld:
    s_lshl_b32 s70, s66, 12
    s_add_u32 s36, s12, s70
    s_addc_u32 s37, s13, 0
    s_and_b32 s37, s37, 0xffff
    s_mov_b32 s38, 4096
    s_mov_b32 s39, 0x20000
    s_add_u32 s40, s14, s70
    s_addc_u32 s41, s15, 0
    s_and_b32 s41, s41, 0xffff
    s_mov_b32 s42, 4096
    s_mov_b32 s43, 0x20000
    s_lshr_b32 s70, s66, 4
    s_lshl_b32 s70, s70, 9
    s_add_u32 s44, s16, s70
    s_addc_u32 s45, s17, 0
    s_and_b32 s45, s45, 0xffff
    s_mov_b32 s46, 512
    s_mov_b32 s47, 0x20000
    s_add_u32 m0, s61, 16384
    v_and_b32 v235, 15, v1
    buffer_load_dwordx4 v2, s[36:39], 0 offen offset:0 lds
    buffer_load_dwordx4 v3, s[36:39], 0 offen offset:1024 lds
    buffer_load_dwordx4 v4, s[36:39], 0 offen offset:2048 lds
    buffer_load_dwordx4 v5, s[36:39], 0 offen offset:3072 lds
    s_mov_b32 m0, 147456
    v_lshrrev_b32 v236, 5, v1
    buffer_load_dwordx4 v6, s[40:43], 0 offen offset:0 lds
    buffer_load_dwordx4 v6, s[40:43], 0 offen offset:1024 lds
    buffer_load_dwordx4 v6, s[40:43], 0 offen offset:2048 lds
    buffer_load_dwordx4 v6, s[40:43], 0 offen offset:3072 lds
    v_lshlrev_b32 v235, 5, v235
    v_lshl_add_u32 v235, v236, 3, v235
    buffer_load_dwordx2 v[112:113], v235, s[44:47], 0 offen
    buffer_load_dwordx2 v[114:115], v235, s[44:47], 0 offen offset:16
    s_branch L_tree_ld_ret
L_u2:
    v_mov_b32 v12, v11
    s_nop 1
    v_permlane32_swap_b32 v11, v12
    v_max_f32 v11, v11, v12
    v_mul_f32 v11, s65, v11
    v_ceil_f32 v11, v11
    v_max_f32 v11, v11, v9
    v_sub_f32 v12, v9, v11
    v_mov_b32 v9, v11
    v_exp_f32 v10, v12
    v_add_f32 v240, 0x41000000, v11
    v_mul_f32 v240, 0x40faf233, v240
    v_mul_f32 v8, v8, v10
    s_branch L_u3
L_u20:
    v_mov_b32 v12, v11
    s_nop 1
    v_permlane32_swap_b32 v11, v12
    v_max_f32 v11, v11, v12
    v_mul_f32 v11, s65, v11
    v_ceil_f32 v11, v11
    v_max_f32 v11, v11, v9
    v_sub_f32 v12, v9, v11
    v_mov_b32 v9, v11
    v_exp_f32 v10, v12
    v_add_f32 v240, 0x41000000, v11
    v_mul_f32 v240, 0x40faf233, v240
    v_mul_f32 v8, v8, v10
    s_branch L_u21
L_switch:
    s_lshl_b32 s68, s66, 21
    s_add_u32 s24, s10, s68
    s_addc_u32 s25, s11, 0
    s_and_b32 s25, s25, 0xffff
    s_lshl_b32 s62, s67, 2
    s_add_u32 s62, s62, s60
    s_lshl_b32 s62, s62, 12
    s_add_u32 s63, s62, 65536
    v_mov_b32 v2, v6
    v_mov_b32 v3, v6
    v_mov_b32 v4, v6
    v_mov_b32 v5, v6
    s_mov_b32 s100, 0
    s_branch L_switch_ret
L_kloop:
    s_xor_b32 s92, s92, s59
    s_xor_b32 s93, s93, s59
    s_xor_b32 s94, s94, s59
    s_xor_b32 s95, s95, s59
    s_add_u32 s62, s62, 98304
    s_add_u32 s63, s63, 98304
    s_waitcnt vmcnt(9)
    v_sub_u32 v245, v242, v241
    v_cmp_gt_u32 s[6:7], 5, v245
    s_add_u32 s101, s101, s98
    s_cselect_b32 s79, 1, 0
    s_bcnt1_i32_b64 s68, s[6:7]
    s_cmp_ge_u32 s68, s100
    s_cselect_b32 s3, 1, s79
    s_cmp_eq_u32 s64, 30
    s_cbranch_scc1 L_switch
L_switch_ret:
    s_waitcnt vmcnt(8)
    s_barrier
    s_cmp_eq_u32 s3, 1
    v_add_u32 v241, 1, v241
    buffer_load_dword v242, v243, s[28:31], 0 offen sc1
    s_mov_b32 m0, s92
    s_waitcnt vmcnt(7)
    s_cbranch_scc1 L_u5
    s_waitcnt vmcnt(6)
L_u5:
    buffer_load_dwordx4 v2, s[24:27], s62 offen offset:0 nt lds
L_u4:
    ds_read_b128 v[64:67], v16 offset:0
    ds_read_b128 v[68:71], v17 offset:0
    ds_read_b128 v[72:75], v18 offset:0
    ds_read_b128 v[76:79], v19 offset:0
    ds_read_b128 v[80:83], v20 offset:0
    ds_read_b128 v[84:87], v21 offset:0
    ds_read_b128 v[88:91], v22 offset:0
    ds_read_b128 v[92:95], v23 offset:0
    s_waitcnt lgkmcnt(6)
    s_mov_b32 m0, s93
    s_waitcnt vmcnt(7)
    s_cbranch_scc1 L_u7
    s_waitcnt vmcnt(5)
L_u7:
    buffer_load_dwordx4 v2, s[24:27], s63 offen offset:0 nt lds
L_u6:
    v_mfma_f32_32x32x16_bf16 v[96:111], v[64:67], v[32:35], 0
    v_mfma_f32_32x32x16_bf16 v[96:111], v[68:71], v[36:39], v[96:111]
    s_waitcnt lgkmcnt(4)
    v_mfma_f32_32x32x16_bf16 v[96:111], v[72:75], v[40:43], v[96:111]
    s_mov_b32 m0, s92
    s_waitcnt vmcnt(6)
    s_cbranch_scc1 L_u9
    s_waitcnt vmcnt(5)
L_u9:
    buffer_load_dwordx4 v3, s[24:27], s62 offen offset:1024 nt lds
L_u8:
    v_mfma_f32_32x32x16_bf16 v[96:111], v[76:79], v[44:47], v[96:111]
    s_waitcnt lgkmcnt(2)
    v_mfma_f32_32x32x16_bf16 v[96:111], v[80:83], v[48:51], v[96:111]
    v_mfma_f32_32x32x16_bf16 v[96:111], v[84:87], v[52:55], v[96:111]
    s_mov_b32 m0, s93
    s_waitcnt vmcnt(6)
    s_cbranch_scc1 L_u11
    s_waitcnt vmcnt(5)
L_u11:
    buffer_load_dwordx4 v3, s[24:27], s63 offen offset:1024 nt lds
L_u10:
    s_waitcnt lgkmcnt(0)
    v_mfma_f32_32x32x16_bf16 v[96:111], v[88:91], v[56:59], v[96:111]
    v_mfma_f32_32x32x16_bf16 v[96:111], v[92:95], v[60:63], v[96:111]
    s_nop 7
    buffer_store_dword v241, v244, s[28:31], 0 offen
    s_mov_b32 m0, s92
    s_waitcnt vmcnt(7)
    s_cbranch_scc1 L_u13
    s_waitcnt vmcnt(6)
L_u13:
    buffer_load_dwordx4 v4, s[24:27], s62 offen offset:2048 nt lds
L_u12:
    s_nop 3
    v_max3_f32 v11, v96, v97, v98
    v_max3_f32 v12, v99, v100, v101
    v_max3_f32 v11, v102, v103, v11
    v_max3_f32 v12, v104, v105, v12
    v_max3_f32 v11, v106, v107, v11
    v_max3_f32 v12, v108, v109, v12
    v_max3_f32 v11, v110, v111, v11
    v_max_f32 v11, v11, v12
    v_cmp_nle_f32 vcc, v11, v240
    s_nop 0
    s_cbranch_vccnz L_u2
L_u3:
    v_fma_f32 v96, v96, s65, -v9
    v_fma_f32 v97, v97, s65, -v9
    v_fma_f32 v98, v98, s65, -v9
    v_fma_f32 v99, v99, s65, -v9
    s_mov_b32 m0, s93
    s_waitcnt vmcnt(7)
    s_cbranch_scc1 L_u15
    s_waitcnt vmcnt(5)
L_u15:
    buffer_load_dwordx4 v4, s[24:27], s63 offen offset:2048 nt lds
L_u14:
    v_fma_f32 v100, v100, s65, -v9
    v_fma_f32 v101, v101, s65, -v9
    v_fma_f32 v102, v102, s65, -v9
    v_fma_f32 v103, v103, s65, -v9
    v_fma_f32 v104, v104, s65, -v9
    v_fma_f32 v105, v105, s65, -v9
    v_fma_f32 v106, v106, s65, -v9
    v_fma_f32 v107, v107, s65, -v9
    v_fma_f32 v108, v108, s65, -v9
    v_fma_f32 v109, v109, s65, -v9
    v_fma_f32 v110, v110, s65, -v9
    v_fma_f32 v111, v111, s65, -v9
    v_exp_f32 v96, v96
    v_exp_f32 v97, v97
    v_exp_f32 v98, v98
    v_exp_f32 v99, v99
    v_exp_f32 v100, v100
    v_exp_f32 v101, v101
    v_exp_f32 v102, v102
    s_mov_b32 m0, s92
    s_waitcnt vmcnt(6)
    s_cbranch_scc1 L_u17
    s_waitcnt vmcnt(5)
L_u17:
    buffer_load_dwordx4 v5, s[24:27], s62 offen offset:3072 nt lds
L_u16:
    v_exp_f32 v103, v103
    v_exp_f32 v104, v104
    v_exp_f32 v105, v105
    v_exp_f32 v106, v106
    v_exp_f32 v107, v107
    v_exp_f32 v108, v108
    v_exp_f32 v109, v109
    v_exp_f32 v110, v110
    v_exp_f32 v111, v111
    v_cvt_pk_bf16_f32 v112, v96, v97
    v_cvt_pk_bf16_f32 v113, v98, v99
    v_cvt_pk_bf16_f32 v116, v100, v101
    v_cvt_pk_bf16_f32 v117, v102, v103
    v_cvt_pk_bf16_f32 v114, v104, v105
    v_cvt_pk_bf16_f32 v115, v106, v107
    s_mov_b32 m0, s93
    s_waitcnt vmcnt(6)
    s_cbranch_scc1 L_u19
    s_waitcnt vmcnt(5)
L_u19:
    buffer_load_dwordx4 v5, s[24:27], s63 offen offset:3072 nt lds
L_u18:
    v_cvt_pk_bf16_f32 v118, v108, v109
    v_cvt_pk_bf16_f32 v119, v110, v111
    v_dot2c_f32_bf16 v8, s73, v112
    v_dot2c_f32_bf16 v8, s73, v113
    v_dot2c_f32_bf16 v8, s73, v114
    v_dot2c_f32_bf16 v8, s73, v115
    v_dot2c_f32_bf16 v8, s73, v116
    v_dot2c_f32_bf16 v8, s73, v117
    v_dot2c_f32_bf16 v8, s73, v118
    v_dot2c_f32_bf16 v8, s73, v119
    s_set_gpr_idx_on s96, gpr_idx(DST)
    s_nop 0
    v_accvgpr_write_b32 a0, v112
    v_accvgpr_write_b32 a1, v113
    v_accvgpr_write_b32 a2, v114
    v_accvgpr_write_b32 a3, v115
    v_accvgpr_write_b32 a4, v116
    v_accvgpr_write_b32 a5, v117
    v_accvgpr_write_b32 a6, v118
    v_accvgpr_write_b32 a7, v119
    s_set_gpr_idx_idx s64
    s_nop 0
    v_mov_b32 v120, v9
    s_set_gpr_idx_off
    s_add_u32 s62, s62, 32768
    s_add_u32 s63, s63, 32768
    s_waitcnt vmcnt(9)
    v_sub_u32 v245, v242, v241
    v_cmp_gt_u32 s[6:7], 5, v245
    s_add_u32 s101, s101, s98
    s_cselect_b32 s79, 1, 0
    s_bcnt1_i32_b64 s68, s[6:7]
    s_cmp_ge_u32 s68, s100
    s_cselect_b32 s3, 1, s79
    s_waitcnt vmcnt(8)
    s_barrier
    s_cmp_eq_u32 s3, 1
    v_add_u32 v241, 1, v241
    buffer_load_dword v242, v243, s[28:31], 0 offen sc1
    s_mov_b32 m0, s94
    s_waitcnt vmcnt(7)
    s_cbranch_scc1 L_u23
    s_waitcnt vmcnt(6)
L_u23:
    buffer_load_dwordx4 v2, s[24:27], s62 offen offset:0 nt lds
L_u22:
    ds_read_b128 v[64:67], v16 offset:8192
    ds_read_b128 v[68:71], v17 offset:8192
    ds_read_b128 v[72:75], v18 offset:8192
    ds_read_b128 v[76:79], v19 offset:8192
    ds_read_b128 v[80:83], v20 offset:8192
    ds_read_b128 v[84:87], v21 offset:8192
    ds_read_b128 v[88:91], v22 offset:8192
    ds_read_b128 v[92:95], v23 offset:8192
    s_waitcnt lgkmcnt(6)
    s_mov_b32 m0, s95
    s_waitcnt vmcnt(7)
    s_cbranch_scc1 L_u25
    s_waitcnt vmcnt(5)
L_u25:
    buffer_load_dwordx4 v2, s[24:27], s63 offen offset:0 nt lds
L_u24:
    v_mfma_f32_32x32x16_bf16 v[96:111], v[64:67], v[32:35], 0
    v_mfma_f32_32x32x16_bf16 v[96:111], v[68:71], v[36:39], v[96:111]
    s_waitcnt lgkmcnt(4)
    v_mfma_f32_32x32x16_bf16 v[96:111], v[72:75], v[40:43], v[96:111]
    s_mov_b32 m0, s94
    s_waitcnt vmcnt(6)
    s_cbranch_scc1 L_u27
    s_waitcnt vmcnt(5)
L_u27:
    buffer_load_dwordx4 v3, s[24:27], s62 offen offset:1024 nt lds
L_u26:
    v_mfma_f32_32x32x16_bf16 v[96:111], v[76:79], v[44:47], v[96:111]
    s_waitcnt lgkmcnt(2)
    v_mfma_f32_32x32x16_bf16 v[96:111], v[80:83], v[48:51], v[96:111]
    v_mfma_f32_32x32x16_bf16 v[96:111], v[84:87], v[52:55], v[96:111]
    s_mov_b32 m0, s95
    s_waitcnt vmcnt(6)
    s_cbranch_scc1 L_u29
    s_waitcnt vmcnt(5)
L_u29:
    buffer_load_dwordx4 v3, s[24:27], s63 offen offset:1024 nt lds
L_u28:
    s_waitcnt lgkmcnt(0)
    v_mfma_f32_32x32x16_bf16 v[96:111], v[88:91], v[56:59], v[96:111]
    v_mfma_f32_32x32x16_bf16 v[96:111], v[92:95], v[60:63], v[96:111]
    s_nop 7
    buffer_store_dword v241, v244, s[28:31], 0 offen
    s_mov_b32 m0, s94
    s_waitcnt vmcnt(7)
    s_cbranch_scc1 L_u31
    s_waitcnt vmcnt(6)
L_u31:
    buffer_load_dwordx4 v4, s[24:27], s62 offen offset:2048 nt lds
L_u30:
    s_nop 3
    v_max3_f32 v11, v96, v97, v98
    v_max3_f32 v12, v99, v100, v101
    v_max3_f32 v11, v102, v103, v11
    v_max3_f32 v12, v104, v105, v12
    v_max3_f32 v11, v106, v107, v11
    v_max3_f32 v12, v108, v109, v12
    v_max3_f32 v11, v110, v111, v11
    v_max_f32 v11, v11, v12
    v_cmp_nle_f32 vcc, v11, v240
    s_nop 0
    s_cbranch_vccnz L_u20
L_u21:
    v_fma_f32 v96, v96, s65, -v9
    v_fma_f32 v97, v97, s65, -v9
    v_fma_f32 v98, v98, s65, -v9
    v_fma_f32 v99, v99, s65, -v9
    v_fma_f32 v100, v100, s65, -v9
    v_fma_f32 v101, v101, s65, -v9
    v_fma_f32 v102, v102, s65, -v9
    v_fma_f32 v103, v103, s65, -v9
    v_fma_f32 v104, v104, s65, -v9
    s_mov_b32 m0, s95
    s_waitcnt vmcnt(7)
    s_cbranch_scc1 L_u33
    s_waitcnt vmcnt(5)
L_u33:
    buffer_load_dwordx4 v4, s[24:27], s63 offen offset:2048 nt lds
L_u32:
    v_fma_f32 v105, v105, s65, -v9
    v_fma_f32 v106, v106, s65, -v9
    v_fma_f32 v107, v107, s65, -v9
    v_fma_f32 v108, v108, s65, -v9
    v_fma_f32 v109, v109, s65, -v9
    v_fma_f32 v110, v110, s65, -v9
    v_fma_f32 v111, v111, s65, -v9
    v_exp_f32 v96, v96
    v_exp_f32 v97, v97
    v_exp_f32 v98, v98
    v_exp_f32 v99, v99
    v_exp_f32 v100, v100
    v_exp_f32 v101, v101
    v_exp_f32 v102, v102
    v_exp_f32 v103, v103
    v_exp_f32 v104, v104
    v_exp_f32 v105, v105
    s_mov_b32 m0, s94
    s_waitcnt vmcnt(6)
    s_cbranch_scc1 L_u35
    s_waitcnt vmcnt(5)
L_u35:
    buffer_load_dwordx4 v5, s[24:27], s62 offen offset:3072 nt lds
L_u34:
    v_exp_f32 v106, v106
    v_exp_f32 v107, v107
    v_exp_f32 v108, v108
    v_exp_f32 v109, v109
    v_exp_f32 v110, v110
    v_exp_f32 v111, v111
    v_cvt_pk_bf16_f32 v112, v96, v97
    v_cvt_pk_bf16_f32 v113, v98, v99
    v_cvt_pk_bf16_f32 v116, v100, v101
    v_cvt_pk_bf16_f32 v117, v102, v103
    v_cvt_pk_bf16_f32 v114, v104, v105
    v_cvt_pk_bf16_f32 v115, v106, v107
    v_cvt_pk_bf16_f32 v118, v108, v109
    v_cvt_pk_bf16_f32 v119, v110, v111
    v_dot2c_f32_bf16 v8, s73, v112
    v_dot2c_f32_bf16 v8, s73, v113
    v_dot2c_f32_bf16 v8, s73, v114
    v_dot2c_f32_bf16 v8, s73, v115
    v_dot2c_f32_bf16 v8, s73, v116
    s_mov_b32 m0, s95
    s_waitcnt vmcnt(6)
    s_cbranch_scc1 L_u37
    s_waitcnt vmcnt(5)
L_u37:
    buffer_load_dwordx4 v5, s[24:27], s63 offen offset:3072 nt lds
L_u36:
    v_dot2c_f32_bf16 v8, s73, v117
    v_dot2c_f32_bf16 v8, s73, v118
    v_dot2c_f32_bf16 v8, s73, v119
    s_set_gpr_idx_on s96, gpr_idx(DST)
    s_nop 0
    v_accvgpr_write_b32 a8, v112
    v_accvgpr_write_b32 a9, v113
    v_accvgpr_write_b32 a10, v114
    v_accvgpr_write_b32 a11, v115
    v_accvgpr_write_b32 a12, v116
    v_accvgpr_write_b32 a13, v117
    v_accvgpr_write_b32 a14, v118
    v_accvgpr_write_b32 a15, v119
    s_set_gpr_idx_idx s64
    s_nop 0
    v_mov_b32 v121, v9
    s_set_gpr_idx_off
    v_xor_b32 v16, s59, v16
    v_xor_b32 v17, s59, v17
    v_xor_b32 v18, s59, v18
    v_xor_b32 v19, s59, v19
    v_xor_b32 v20, s59, v20
    v_xor_b32 v21, s59, v21
    v_xor_b32 v22, s59, v22
    v_xor_b32 v23, s59, v23
    s_add_u32 s96, s96, 16
    s_add_u32 s64, s64, 2
    s_cmp_lt_u32 s64, 32
    s_cbranch_scc1 L_kloop
    v_mov_b32 v11, v8
    v_mov_b32 v12, v8
    v_add_u32 v235, 152576, v234
    s_lshl_b32 s68, s60, 9
    v_permlane32_swap_b32 v11, v12
    v_add_u32 v236, s68, v235
    v_mov_b32 v96, v9
    v_add_f32 v97, v11, v12
    ds_write_b64 v236, v[96:97]
    s_mov_b32 s64, 0
    s_mov_b32 s96, 0
    s_set_gpr_idx_on s96, gpr_idx(SRC0)
    s_nop 0
    v_accvgpr_read_b32 v112, a0
    v_accvgpr_read_b32 v113, a1
    v_accvgpr_read_b32 v114, a2
    v_accvgpr_read_b32 v115, a3
    v_accvgpr_read_b32 v116, a4
    v_accvgpr_read_b32 v117, a5
    v_accvgpr_read_b32 v118, a6
    v_accvgpr_read_b32 v119, a7
    s_set_gpr_idx_idx s64
    s_nop 0
    v_mov_b32 v10, v120
    s_set_gpr_idx_off
    s_waitcnt lgkmcnt(0)
    s_barrier
    ds_read_b64 v[160:161], v235 offset:0
    ds_read_b64 v[162:163], v235 offset:512
    ds_read_b64 v[164:165], v235 offset:1024
    ds_read_b64 v[166:167], v235 offset:1536
    v_mov_b32 v11, v157
    s_waitcnt lgkmcnt(0)
    v_max3_f32 v157, v160, v162, v164
    v_max_f32 v157, v157, v166
    v_sub_f32 v159, v157, v10
    v_min_f32 v159, 0x437f0000, v159
    v_cvt_u32_f32 v159, v159
    v_mul_u32_u24 v159, 0x800080, v159
    v_pk_sub_u16 v112, v112, v159 clamp
    v_pk_sub_u16 v113, v113, v159 clamp
    v_pk_sub_u16 v114, v114, v159 clamp
    v_pk_sub_u16 v115, v115, v159 clamp
    v_pk_sub_u16 v116, v116, v159 clamp
    v_pk_sub_u16 v117, v117, v159 clamp
    v_pk_sub_u16 v118, v118, v159 clamp
    v_pk_sub_u16 v119, v119, v159 clamp
    ds_write_b128 v27, v[112:115] offset:0
    ds_write_b128 v27, v[116:119] offset:1024
    s_lshl_b32 s68, s67, 2
    s_add_u32 s68, s68, s60
    s_cmp_eq_u32 s68, 7
    s_cbranch_scc1 L_treep
L_treep_ret:
    s_cmp_eq_u32 s74, 1
    s_cbranch_scc1 L_oscale
L_vloop:
    s_xor_b32 s92, s92, s59
    s_xor_b32 s93, s93, s59
    s_xor_b32 s94, s94, s59
    s_xor_b32 s95, s95, s59
    s_add_u32 s62, s62, 98304
    s_add_u32 s63, s63, 98304
    s_waitcnt vmcnt(9)
    v_sub_u32 v245, v242, v241
    v_cmp_gt_u32 s[6:7], 5, v245
    s_add_u32 s101, s101, s98
    s_cselect_b32 s79, 1, 0
    s_bcnt1_i32_b64 s68, s[6:7]
    s_cmp_ge_u32 s68, s100
    s_cselect_b32 s3, 1, s79
    s_bitcmp1_b32 1, s67
    s_cselect_b32 s68, 26, 63
    s_cmp_eq_u32 s64, s68
    s_cmov_b32 s100, 0
    s_cmp_eq_u32 s64, 30
    s_cselect_b64 vcc, -1, 0
    s_bitcmp1_b32 0x505051, s64
    s_waitcnt vmcnt(8) lgkmcnt(0)
    s_barrier
    s_cbranch_scc1 L_ckA
L_ckA_ret:
    s_cmp_eq_u32 s3, 1
    s_cbranch_vccnz L_u38
    v_add_u32 v241, 1, v241
    buffer_load_dword v242, v243, s[28:31], 0 offen sc1
    s_mov_b32 m0, s92
    s_waitcnt vmcnt(7)
    s_cbranch_scc1 L_u39
    s_waitcnt vmcnt(6)
L_u39:
    buffer_load_dwordx4 v2, s[24:27], s62 offen offset:0 nt lds
L_u38:
    ds_read_b128 v[168:171], v26 offset:0
    ds_read_b64_tr_b16 v[64:65], v24 offset:0
    ds_read_b64_tr_b16 v[66:67], v24 offset:4096
    ds_read_b128 v[172:175], v26 offset:1024
    ds_read_b64_tr_b16 v[68:69], v24 offset:2048
    ds_read_b64_tr_b16 v[70:71], v24 offset:6144
    ds_read_b128 v[176:179], v26 offset:2048
    ds_read_b64_tr_b16 v[72:73], v24 offset:32768
    ds_read_b64_tr_b16 v[74:75], v24 offset:36864
    ds_read_b128 v[180:183], v26 offset:3072
    ds_read_b64_tr_b16 v[76:77], v24 offset:34816
    ds_read_b64_tr_b16 v[78:79], v24 offset:38912
    ds_read_b128 v[184:187], v26 offset:4096
    s_cbranch_vccnz L_u40
    s_mov_b32 m0, s93
    s_waitcnt vmcnt(7)
    s_cbranch_scc1 L_u41
    s_waitcnt vmcnt(5)
L_u41:
    buffer_load_dwordx4 v2, s[24:27], s63 offen offset:0 nt lds
L_u40:
    ds_read_b64_tr_b16 v[80:81], v25 offset:0
    ds_read_b64_tr_b16 v[82:83], v25 offset:4096
    s_waitcnt lgkmcnt(12)
    v_mfma_f32_32x32x16_bf16 v[200:215], v[64:67], v[168:171], v[200:215]
    ds_read_b128 v[188:191], v26 offset:5120
    s_cbranch_vccnz L_u42
    s_mov_b32 m0, s92
    s_waitcnt vmcnt(6)
    s_cbranch_scc1 L_u43
    s_waitcnt vmcnt(5)
L_u43:
    buffer_load_dwordx4 v3, s[24:27], s62 offen offset:1024 nt lds
L_u42:
    ds_read_b64_tr_b16 v[84:85], v25 offset:2048
    ds_read_b64_tr_b16 v[86:87], v25 offset:6144
    s_waitcnt lgkmcnt(12)
    v_mfma_f32_32x32x16_bf16 v[200:215], v[68:71], v[172:175], v[200:215]
    ds_read_b128 v[192:195], v26 offset:6144
    ds_read_b64_tr_b16 v[88:89], v25 offset:32768
    s_cbranch_vccnz L_u44
    s_mov_b32 m0, s93
    s_waitcnt vmcnt(6)
    s_cbranch_scc1 L_u45
    s_waitcnt vmcnt(5)
L_u45:
    buffer_load_dwordx4 v3, s[24:27], s63 offen offset:1024 nt lds
L_u44:
    ds_read_b64_tr_b16 v[90:91], v25 offset:36864
    s_waitcnt lgkmcnt(12)
    v_mfma_f32_32x32x16_bf16 v[200:215], v[72:75], v[176:179], v[200:215]
    ds_read_b128 v[196:199], v26 offset:7168
    ds_read_b64_tr_b16 v[92:93], v25 offset:34816
    s_cbranch_vccnz L_u46
    buffer_store_dword v241, v244, s[28:31], 0 offen
    s_mov_b32 m0, s92
    s_waitcnt vmcnt(7)
    s_cbranch_scc1 L_u47
    s_waitcnt vmcnt(6)
L_u47:
    buffer_load_dwordx4 v4, s[24:27], s62 offen offset:2048 nt lds
L_u46:
    ds_read_b64_tr_b16 v[94:95], v25 offset:38912
    s_waitcnt lgkmcnt(12)
    v_mfma_f32_32x32x16_bf16 v[200:215], v[76:79], v[180:183], v[200:215]
    s_set_gpr_idx_on s96, gpr_idx(SRC0)
    s_nop 0
    v_accvgpr_read_b32 v112, a8
    v_accvgpr_read_b32 v113, a9
    v_accvgpr_read_b32 v114, a10
    v_accvgpr_read_b32 v115, a11
    v_accvgpr_read_b32 v116, a12
    v_accvgpr_read_b32 v117, a13
    v_accvgpr_read_b32 v118, a14
    v_accvgpr_read_b32 v119, a15
    s_set_gpr_idx_idx s64
    s_nop 0
    v_mov_b32 v10, v121
    s_set_gpr_idx_off
    s_cbranch_vccnz L_u48
    s_mov_b32 m0, s93
    s_waitcnt vmcnt(7)
    s_cbranch_scc1 L_u49
    s_waitcnt vmcnt(5)
L_u49:
    buffer_load_dwordx4 v4, s[24:27], s63 offen offset:2048 nt lds
L_u48:
    s_waitcnt lgkmcnt(9)
    v_mfma_f32_32x32x16_bf16 v[200:215], v[80:83], v[184:187], v[200:215]
    v_sub_f32 v159, v157, v10
    v_min_f32 v159, 0x437f0000, v159
    v_cvt_u32_f32 v159, v159
    v_mul_u32_u24 v159, 0x800080, v159
    s_cbranch_vccnz L_u50
    s_mov_b32 m0, s92
    s_waitcnt vmcnt(6)
    s_cbranch_scc1 L_u51
    s_waitcnt vmcnt(5)
L_u51:
    buffer_load_dwordx4 v5, s[24:27], s62 offen offset:3072 nt lds
L_u50:
    v_pk_sub_u16 v112, v112, v159 clamp
    s_waitcnt lgkmcnt(6)
    v_mfma_f32_32x32x16_bf16 v[200:215], v[84:87], v[188:191], v[200:215]
    v_pk_sub_u16 v113, v113, v159 clamp
    v_pk_sub_u16 v114, v114, v159 clamp
    v_pk_sub_u16 v115, v115, v159 clamp
    v_pk_sub_u16 v116, v116, v159 clamp
    v_pk_sub_u16 v117, v117, v159 clamp
    s_waitcnt lgkmcnt(3)
    s_cbranch_vccnz L_u52
    s_mov_b32 m0, s93
    s_waitcnt vmcnt(6)
    s_cbranch_scc1 L_u53
    s_waitcnt vmcnt(5)
L_u53:
    buffer_load_dwordx4 v5, s[24:27], s63 offen offset:3072 nt lds
L_u52:
    v_mfma_f32_32x32x16_bf16 v[200:215], v[88:91], v[192:195], v[200:215]
    v_pk_sub_u16 v118, v118, v159 clamp
    v_pk_sub_u16 v119, v119, v159 clamp
    s_waitcnt lgkmcnt(0)
    v_mfma_f32_32x32x16_bf16 v[200:215], v[92:95], v[196:199], v[200:215]
    ds_write_b128 v27, v[112:115] offset:8192
    ds_write_b128 v27, v[116:119] offset:9216
    s_add_u32 s62, s62, 32768
    s_add_u32 s63, s63, 32768
    s_waitcnt vmcnt(9)
    v_sub_u32 v245, v242, v241
    v_cmp_gt_u32 s[6:7], 5, v245
    s_add_u32 s101, s101, s98
    s_cselect_b32 s79, 1, 0
    s_bcnt1_i32_b64 s68, s[6:7]
    s_cmp_ge_u32 s68, s100
    s_cselect_b32 s3, 1, s79
    s_cmp_eq_u32 s64, s97
    s_cmov_b32 s3, 3
    s_cbranch_vccnz L_final
    s_waitcnt vmcnt(8) lgkmcnt(0)
    s_barrier
    s_cmp_eq_u32 s3, 1
    v_add_u32 v241, 1, v241
    buffer_load_dword v242, v243, s[28:31], 0 offen sc1
    s_mov_b32 m0, s94
    s_cmp_eq_u32 s3, 3
    s_cbranch_scc1 L_u55
    s_cmp_eq_u32 s3, 1
    s_waitcnt vmcnt(7)
    s_cbranch_scc1 L_u55
    s_waitcnt vmcnt(6)
L_u55:
    buffer_load_dwordx4 v2, s[24:27], s62 offen offset:0 nt lds
L_u54:
    ds_read_b128 v[168:171], v26 offset:8192
    ds_read_b64_tr_b16 v[64:65], v24 offset:8192
    ds_read_b64_tr_b16 v[66:67], v24 offset:12288
    ds_read_b128 v[172:175], v26 offset:9216
    ds_read_b64_tr_b16 v[68:69], v24 offset:10240
    ds_read_b64_tr_b16 v[70:71], v24 offset:14336
    ds_read_b128 v[176:179], v26 offset:10240
    ds_read_b64_tr_b16 v[72:73], v24 offset:40960
    ds_read_b64_tr_b16 v[74:75], v24 offset:45056
    ds_read_b128 v[180:183], v26 offset:11264
    ds_read_b64_tr_b16 v[76:77], v24 offset:43008
    ds_read_b64_tr_b16 v[78:79], v24 offset:47104
    ds_read_b128 v[184:187], v26 offset:12288
    s_mov_b32 m0, s95
    s_cmp_eq_u32 s3, 3
    s_cbranch_scc1 L_u57
    s_cmp_eq_u32 s3, 1
    s_waitcnt vmcnt(7)
    s_cbranch_scc1 L_u57
    s_waitcnt vmcnt(5)
L_u57:
    buffer_load_dwordx4 v2, s[24:27], s63 offen offset:0 nt lds
L_u56:
    ds_read_b64_tr_b16 v[80:81], v25 offset:8192
    ds_read_b64_tr_b16 v[82:83], v25 offset:12288
    s_waitcnt lgkmcnt(12)
    v_mfma_f32_32x32x16_bf16 v[200:215], v[64:67], v[168:171], v[200:215]
    ds_read_b128 v[188:191], v26 offset:13312
    s_mov_b32 m0, s94
    s_cmp_eq_u32 s3, 3
    s_cbranch_scc1 L_u59
    s_cmp_eq_u32 s3, 1
    s_waitcnt vmcnt(6)
    s_cbranch_scc1 L_u59
    s_waitcnt vmcnt(5)
L_u59:
    buffer_load_dwordx4 v3, s[24:27], s62 offen offset:1024 nt lds
L_u58:
    ds_read_b64_tr_b16 v[84:85], v25 offset:10240
    ds_read_b64_tr_b16 v[86:87], v25 offset:14336
    s_waitcnt lgkmcnt(12)
    v_mfma_f32_32x32x16_bf16 v[200:215], v[68:71], v[172:175], v[200:215]
    ds_read_b128 v[192:195], v26 offset:14336
    ds_read_b64_tr_b16 v[88:89], v25 offset:40960
    s_mov_b32 m0, s95
    s_cmp_eq_u32 s3, 3
    s_cbranch_scc1 L_u61
    s_cmp_eq_u32 s3, 1
    s_waitcnt vmcnt(6)
    s_cbranch_scc1 L_u61
    s_waitcnt vmcnt(5)
L_u61:
    buffer_load_dwordx4 v3, s[24:27], s63 offen offset:1024 nt lds
L_u60:
    ds_read_b64_tr_b16 v[90:91], v25 offset:45056
    s_waitcnt lgkmcnt(12)
    v_mfma_f32_32x32x16_bf16 v[200:215], v[72:75], v[176:179], v[200:215]
    ds_read_b128 v[196:199], v26 offset:15360
    ds_read_b64_tr_b16 v[92:93], v25 offset:43008
    buffer_store_dword v241, v244, s[28:31], 0 offen
    s_mov_b32 m0, s94
    s_cmp_eq_u32 s3, 3
    s_cbranch_scc1 L_u63
    s_cmp_eq_u32 s3, 1
    s_waitcnt vmcnt(7)
    s_cbranch_scc1 L_u63
    s_waitcnt vmcnt(6)
L_u63:
    buffer_load_dwordx4 v4, s[24:27], s62 offen offset:2048 nt lds
L_u62:
    ds_read_b64_tr_b16 v[94:95], v25 offset:47104
    s_waitcnt lgkmcnt(12)
    v_mfma_f32_32x32x16_bf16 v[200:215], v[76:79], v[180:183], v[200:215]
    s_set_gpr_idx_on s96, gpr_idx(SRC0)
    s_nop 0
    v_accvgpr_read_b32 v112, a16
    v_accvgpr_read_b32 v113, a17
    v_accvgpr_read_b32 v114, a18
    v_accvgpr_read_b32 v115, a19
    v_accvgpr_read_b32 v116, a20
    v_accvgpr_read_b32 v117, a21
    v_accvgpr_read_b32 v118, a22
    v_accvgpr_read_b32 v119, a23
    s_set_gpr_idx_idx s64
    s_nop 0
    v_mov_b32 v10, v122
    s_set_gpr_idx_off
    s_mov_b32 m0, s95
    s_cmp_eq_u32 s3, 3
    s_cbranch_scc1 L_u65
    s_cmp_eq_u32 s3, 1
    s_waitcnt vmcnt(7)
    s_cbranch_scc1 L_u65
    s_waitcnt vmcnt(5)
L_u65:
    buffer_load_dwordx4 v4, s[24:27], s63 offen offset:2048 nt lds
L_u64:
    s_waitcnt lgkmcnt(9)
    v_mfma_f32_32x32x16_bf16 v[200:215], v[80:83], v[184:187], v[200:215]
    v_sub_f32 v159, v157, v10
    v_min_f32 v159, 0x437f0000, v159
    v_cvt_u32_f32 v159, v159
    v_mul_u32_u24 v159, 0x800080, v159
    v_pk_sub_u16 v112, v112, v159 clamp
    s_waitcnt lgkmcnt(6)
    s_mov_b32 m0, s94
    s_cmp_eq_u32 s3, 3
    s_cbranch_scc1 L_u67
    s_cmp_eq_u32 s3, 1
    s_waitcnt vmcnt(6)
    s_cbranch_scc1 L_u67
    s_waitcnt vmcnt(5)
L_u67:
    buffer_load_dwordx4 v5, s[24:27], s62 offen offset:3072 nt lds
L_u66:
    v_mfma_f32_32x32x16_bf16 v[200:215], v[84:87], v[188:191], v[200:215]
    v_pk_sub_u16 v113, v113, v159 clamp
    v_pk_sub_u16 v114, v114, v159 clamp
    v_pk_sub_u16 v115, v115, v159 clamp
    v_pk_sub_u16 v116, v116, v159 clamp
    v_pk_sub_u16 v117, v117, v159 clamp
    s_waitcnt lgkmcnt(3)
    s_mov_b32 m0, s95
    s_cmp_eq_u32 s3, 3
    s_cbranch_scc1 L_u69
    s_cmp_eq_u32 s3, 1
    s_waitcnt vmcnt(6)
    s_cbranch_scc1 L_u69
    s_waitcnt vmcnt(5)
L_u69:
    buffer_load_dwordx4 v5, s[24:27], s63 offen offset:3072 nt lds
L_u68:
    v_mfma_f32_32x32x16_bf16 v[200:215], v[88:91], v[192:195], v[200:215]
    v_pk_sub_u16 v118, v118, v159 clamp
    v_pk_sub_u16 v119, v119, v159 clamp
    v_xor_b32 v24, s59, v24
    v_xor_b32 v25, s59, v25
    s_waitcnt lgkmcnt(0)
    v_mfma_f32_32x32x16_bf16 v[200:215], v[92:95], v[196:199], v[200:215]
    ds_write_b128 v27, v[112:115] offset:0
    ds_write_b128 v27, v[116:119] offset:1024
    s_add_u32 s96, s96, 16
    s_add_u32 s64, s64, 2
    s_branch L_vloop
L_final:
    s_cmp_eq_u32 s72, 2
    buffer_load_dwordx4 v[96:99], v31, s[52:55], 0 offen offset:0 sc1
    buffer_load_dwordx4 v[100:103], v31, s[52:55], 0 offen offset:1024 sc1
    s_waitcnt vmcnt(6) lgkmcnt(0)
    s_barrier
    ds_read_b128 v[168:171], v26 offset:8192
    ds_read_b64_tr_b16 v[64:65], v24 offset:8192
    ds_read_b64_tr_b16 v[66:67], v24 offset:12288
    ds_read_b128 v[176:179], v26 offset:10240
    ds_read_b64_tr_b16 v[72:73], v24 offset:40960
    ds_read_b64_tr_b16 v[74:75], v24 offset:45056
    ds_read_b128 v[184:187], v26 offset:12288
    ds_read_b64_tr_b16 v[80:81], v25 offset:8192
    ds_read_b64_tr_b16 v[82:83], v25 offset:12288
    ds_read_b128 v[192:195], v26 offset:14336
    ds_read_b64_tr_b16 v[88:89], v25 offset:40960
    ds_read_b64_tr_b16 v[90:91], v25 offset:45056
    s_waitcnt lgkmcnt(9)
    v_mfma_f32_32x32x16_bf16 v[200:215], v[64:67], v[168:171], v[200:215]
    ds_read_b128 v[172:175], v26 offset:9216
    s_waitcnt lgkmcnt(7)
    v_mfma_f32_32x32x16_bf16 v[200:215], v[72:75], v[176:179], v[200:215]
    ds_read_b128 v[180:183], v26 offset:11264
    s_waitcnt lgkmcnt(5)
    v_mfma_f32_32x32x16_bf16 v[200:215], v[80:83], v[184:187], v[200:215]
    ds_read_b128 v[188:191], v26 offset:13312
    s_waitcnt lgkmcnt(3)
    v_mfma_f32_32x32x16_bf16 v[200:215], v[88:91], v[192:195], v[200:215]
    ds_read_b128 v[196:199], v26 offset:15360
    s_waitcnt vmcnt(2) lgkmcnt(0)
    s_barrier
    s_cbranch_scc0 L_final2
    buffer_load_dwordx4 v[216:219], v31, s[52:55], 0 offen offset:0 sc1
    buffer_load_dwordx4 v[220:223], v31, s[52:55], 0 offen offset:1024 sc1
L_final2:
    ds_read_b64_tr_b16 v[68:69], v24 offset:10240
    ds_read_b64_tr_b16 v[70:71], v24 offset:14336
    ds_read_b64_tr_b16 v[76:77], v24 offset:43008
    ds_read_b64_tr_b16 v[78:79], v24 offset:47104
    ds_read_b64_tr_b16 v[84:85], v25 offset:10240
    ds_read_b64_tr_b16 v[86:87], v25 offset:14336
    ds_read_b64_tr_b16 v[92:93], v25 offset:43008
    ds_read_b64_tr_b16 v[94:95], v25 offset:47104
    s_waitcnt lgkmcnt(6)
    v_mfma_f32_32x32x16_bf16 v[200:215], v[68:71], v[172:175], v[200:215]
    s_waitcnt lgkmcnt(4)
    v_mfma_f32_32x32x16_bf16 v[200:215], v[76:79], v[180:183], v[200:215]
    s_waitcnt lgkmcnt(2)
    v_mfma_f32_32x32x16_bf16 v[200:215], v[84:87], v[188:191], v[200:215]
    s_waitcnt lgkmcnt(0)
    v_mfma_f32_32x32x16_bf16 v[200:215], v[92:95], v[196:199], v[200:215]
    s_mov_b32 s99, 0
    s_cmp_eq_u32 s72, 3
    s_cbranch_scc1 L_solo
L_scale:
    s_nop 7
    s_cmp_ge_u32 s72, 2
    v_mul_f32 v200, v246, v200
    v_mul_f32 v201, v246, v201
    v_mul_f32 v202, v246, v202
    v_mul_f32 v203, v246, v203
    v_mul_f32 v204, v246, v204
    v_mul_f32 v205, v246, v205
    v_mul_f32 v206, v246, v206
    v_mul_f32 v207, v246, v207
    v_mul_f32 v208, v246, v208
    v_mul_f32 v209, v246, v209
    v_mul_f32 v210, v246, v210
    v_mul_f32 v211, v246, v211
    v_mul_f32 v212, v246, v212
    v_mul_f32 v213, v246, v213
    v_mul_f32 v214, v246, v214
    v_mul_f32 v215, v246, v215
    s_cbranch_scc1 L_poll_chk
    s_cmp_eq_u32 s72, 1
    s_cbranch_scc0 L_done
    v_cvt_pk_bf16_f32 v112, v200, v201
    v_cvt_pk_bf16_f32 v113, v202, v203
    v_cvt_pk_bf16_f32 v114, v204, v205
    v_cvt_pk_bf16_f32 v115, v206, v207
    v_cvt_pk_bf16_f32 v116, v208, v209
    v_cvt_pk_bf16_f32 v117, v210, v211
    v_cvt_pk_bf16_f32 v118, v212, v213
    v_cvt_pk_bf16_f32 v119, v214, v215
    v_min_u32 v112, -2, v112
    v_min_u32 v113, -2, v113
    v_min_u32 v114, -2, v114
    v_min_u32 v115, -2, v115
    v_min_u32 v116, -2, v116
    v_min_u32 v117, -2, v117
    v_min_u32 v118, -2, v118
    v_min_u32 v119, -2, v119
    buffer_store_dwordx4 v[112:115], v31, s[52:55], 0 offen offset:0
    buffer_store_dwordx4 v[116:119], v31, s[52:55], 0 offen offset:1024
    s_endpgm
L_poll:
    buffer_load_dwordx4 v[216:219], v31, s[52:55], 0 offen offset:0 sc1
    buffer_load_dwordx4 v[220:223], v31, s[52:55], 0 offen offset:1024 sc1
    s_add_u32 s99, s99, 1
    s_cmp_gt_u32 s99, 0x100000
    s_cbranch_scc1 L_done
L_poll_chk:
    s_waitcnt vmcnt(0)
    v_max3_u32 v11, v216, v217, v218
    v_max3_u32 v12, v219, v220, v221
    v_max3_u32 v11, v222, v223, v11
    v_max_u32 v11, v11, v12
    v_cmp_eq_u32 s[6:7], -1, v11
    s_nop 0
    s_cmp_eq_u64 s[6:7], 0
    s_cbranch_scc0 L_poll
L_combine:
    v_and_b32 v224, 0xffff0000, v216
    v_lshlrev_b32 v216, 16, v216
    v_and_b32 v225, 0xffff0000, v217
    v_lshlrev_b32 v217, 16, v217
    v_and_b32 v226, 0xffff0000, v218
    v_lshlrev_b32 v218, 16, v218
    v_and_b32 v227, 0xffff0000, v219
    v_lshlrev_b32 v219, 16, v219
    v_and_b32 v228, 0xffff0000, v220
    v_lshlrev_b32 v220, 16, v220
    v_and_b32 v229, 0xffff0000, v221
    v_lshlrev_b32 v221, 16, v221
    v_and_b32 v230, 0xffff0000, v222
    v_lshlrev_b32 v222, 16, v222
    v_and_b32 v231, 0xffff0000, v223
    v_lshlrev_b32 v223, 16, v223
    v_fmac_f32 v200, v247, v216
    v_fmac_f32 v201, v247, v224
    v_fmac_f32 v202, v247, v217
    v_fmac_f32 v203, v247, v225
    v_fmac_f32 v204, v247, v218
    v_fmac_f32 v205, v247, v226
    v_fmac_f32 v206, v247, v219
    v_fmac_f32 v207, v247, v227
    v_fmac_f32 v208, v247, v220
    v_fmac_f32 v209, v247, v228
    v_fmac_f32 v210, v247, v221
    v_fmac_f32 v211, v247, v229
    v_fmac_f32 v212, v247, v222
    v_fmac_f32 v213, v247, v230
    v_fmac_f32 v214, v247, v223
    v_fmac_f32 v215, v247, v231
    v_cvt_pk_bf16_f32 v112, v200, v201
    v_cvt_pk_bf16_f32 v113, v202, v203
    v_cvt_pk_bf16_f32 v114, v204, v205
    v_cvt_pk_bf16_f32 v115, v206, v207
    v_cvt_pk_bf16_f32 v116, v208, v209
    v_cvt_pk_bf16_f32 v117, v210, v211
    v_cvt_pk_bf16_f32 v118, v212, v213
    v_cvt_pk_bf16_f32 v119, v214, v215
    ds_write_b64 v30, v[112:113] offset:0
    ds_write_b64 v30, v[114:115] offset:16
    ds_write_b64 v30, v[116:117] offset:32
    ds_write_b64 v30, v[118:119] offset:48
    ds_read_b128 v[96:99], v239 offset:0
    ds_read_b128 v[100:103], v239 offset:1280
    s_waitcnt lgkmcnt(1)
    buffer_store_dwordx4 v[96:99], v15, s[48:51], s77 offen
    s_waitcnt lgkmcnt(0)
    buffer_store_dwordx4 v[100:103], v15, s[48:51], s58 offen
L_done:
    s_endpgm
L_ckA:
    s_cmp_eq_u32 s64, 0
    s_cbranch_scc1 L_ckA0
    s_cmp_eq_u32 s72, 1
    s_cbranch_scc0 L_ckA_con
    s_cmp_eq_u32 s64, 14
    s_cbranch_scc1 L_ckA22
    s_cmp_eq_u32 s64, 12
    s_cbranch_scc0 L_ckA_ret
    buffer_load_dword v216, off, s[52:55], s76 sc1
    s_mov_b32 s3, 1
    s_branch L_ckA_ret
L_ckA22:
    v_add_u32 v28, 16, v28
    v_and_b32 v28, -16, v28
    v_or_b32 v28, s75, v28
    v_cmp_ne_u32 s[6:7], v28, v216
    v_sub_f32 v104, v160, v157
    v_sub_f32 v105, v162, v157
    v_sub_f32 v106, v164, v157
    v_sub_f32 v107, v166, v157
    v_exp_f32 v104, v104
    v_exp_f32 v105, v105
    v_exp_f32 v106, v106
    v_exp_f32 v107, v107
    v_mul_f32 v158, v104, v161
    v_fmac_f32 v158, v105, v163
    v_fmac_f32 v158, v106, v165
    v_fmac_f32 v158, v107, v167
    s_bitcmp0_b32 s6, 0
    s_cselect_b32 s72, 1, 0
    s_cmp_eq_u32 s72, 1
    s_cbranch_scc0 L_ckA_ret
    v_min_u32 v232, -2, v157
    v_min_u32 v233, -2, v158
    v_rcp_f32 v246, v158
    buffer_store_dwordx2 v[232:233], v234, s[52:55], s78 offen
    s_mov_b32 s3, 1
    s_branch L_ckA_ret
L_ckA_con:
    s_cmp_eq_u32 s64, 22
    s_cbranch_scc1 L_ckA28
    s_cmp_eq_u32 s72, 2
    s_cbranch_scc0 L_ckA_ret
    s_cmp_eq_u32 s64, 20
    s_cbranch_scc1 L_ckA26
    s_cmp_eq_u32 s64, 6
    s_cbranch_scc1 L_ckA_tag
    s_cmp_eq_u32 s64, 4
    s_cbranch_scc0 L_ckA_ret
    v_mov_b32 v216, -1
    v_mov_b32 v217, -1
    v_mov_b32 v218, -1
    v_mov_b32 v219, -1
    buffer_store_dwordx2 v[216:217], v234, s[52:55], s78 offen
    buffer_store_dwordx4 v[216:219], v31, s[52:55], 0 offen offset:0
    buffer_store_dwordx4 v[216:219], v31, s[52:55], 0 offen offset:1024
    s_mov_b32 s3, 1
    s_mov_b32 s100, 0
    s_branch L_ckA_ret
L_ckA_tag:
    v_add_u32 v28, 16, v28
    v_and_b32 v28, -16, v28
    v_or_b32 v28, s75, v28
    s_mov_b64 exec, 1
    buffer_store_dword v28, off, s[52:55], s76
    s_mov_b64 exec, -1
    s_mov_b32 s100, 32
    s_branch L_ckA_ret
L_ckA26:
    buffer_load_dwordx2 v[232:233], v234, s[52:55], s78 offen sc1
    s_mov_b32 s3, 1
    s_branch L_ckA_ret
L_ckA28:
    s_cmp_eq_u32 s72, 0
    s_cbranch_scc1 L_ckA_ret
    s_cmp_eq_u32 s72, 2
    s_cbranch_scc0 L_ckA28b
    v_max_u32 v11, v232, v233
    s_lshl_b32 s68, s60, 2
    v_cmp_eq_u32 s[6:7], -1, v11
    v_add_u32 v12, s68, v29
    s_or_b32 s68, s6, s7
    v_mov_b32 v11, s68
    ds_write_b32 v12, v11
    s_waitcnt lgkmcnt(0)
    s_barrier
    ds_read_b128 v[216:219], v29
    v_sub_f32 v104, v160, v157
    v_sub_f32 v105, v162, v157
    v_sub_f32 v106, v164, v157
    v_sub_f32 v107, v166, v157
    v_exp_f32 v104, v104
    v_exp_f32 v105, v105
    v_exp_f32 v106, v106
    v_exp_f32 v107, v107
    v_mul_f32 v158, v104, v161
    v_fmac_f32 v158, v105, v163
    v_fmac_f32 v158, v106, v165
    v_fmac_f32 v158, v107, v167
    v_max_f32 v11, v157, v232
    v_sub_f32 v246, v157, v11
    v_sub_f32 v247, v232, v11
    v_exp_f32 v247, v247
    v_exp_f32 v246, v246
    v_mul_f32 v247, v247, v233
    v_fma_f32 v11, v246, v158, v247
    v_rcp_f32 v11, v11
    s_nop 0
    v_mul_f32 v246, v246, v11
    v_mul_f32 v247, v247, v11
    s_waitcnt lgkmcnt(0)
    v_or_b32 v11, v216, v217
    v_or3_b32 v11, v218, v219, v11
    s_nop 0
    v_readfirstlane_b32 s68, v11
    s_nop 0
    s_cmp_eq_u32 s68, 0
    s_cselect_b32 s72, 2, 3
    s_mov_b32 s3, 1
    s_branch L_ckA_ret
L_ckA0:
    s_mov_b32 s100, 32
    s_cmp_eq_u32 s67, 1
    s_cbranch_scc0 L_ckA_ret
    v_add_u32 v11, 147456, v24
    ds_read_b128 v[168:171], v26 offset:20480
    ds_read_b64_tr_b16 v[64:65], v11
    ds_read_b64_tr_b16 v[66:67], v11 offset:2048
    s_waitcnt lgkmcnt(0)
    v_mfma_f32_32x32x16_bf16 v[200:215], v[64:67], v[168:171], v[200:215]
    s_nop 3
    s_branch L_ckA_ret
L_treep:
    v_sub_f32 v159, v157, v156
    v_min_f32 v159, 0x437f0000, v159
    v_cvt_u32_f32 v159, v159
    v_mul_u32_u24 v159, 0x800080, v159
    v_pk_sub_u16 v152, v152, v159 clamp
    v_pk_sub_u16 v153, v153, v159 clamp
    v_pk_sub_u16 v154, v154, v159 clamp
    v_pk_sub_u16 v155, v155, v159 clamp
    ds_write_b128 v26, v[152:155] offset:20480
    s_branch L_treep_ret
L_tree:
    s_mov_b32 m0, s93
    s_waitcnt vmcnt(19)
    buffer_load_dwordx4 v4, s[24:27], s63 offen offset:2048 nt lds
    s_mov_b32 m0, s92
    s_waitcnt vmcnt(19)
    buffer_load_dwordx4 v5, s[24:27], s62 offen offset:3072 nt lds
    s_mov_b32 m0, s93
    s_waitcnt vmcnt(19)
    buffer_load_dwordx4 v5, s[24:27], s63 offen offset:3072 nt lds
    s_add_u32 s62, s62, 32768
    s_add_u32 s63, s63, 32768
    s_mov_b32 m0, s94
    s_waitcnt vmcnt(19)
    buffer_load_dwordx4 v2, s[24:27], s62 offen offset:0 nt lds
    s_mov_b32 m0, s95
    s_waitcnt vmcnt(19)
    buffer_load_dwordx4 v2, s[24:27], s63 offen offset:0 nt lds
    s_mov_b32 m0, s94
    s_waitcnt vmcnt(4)
    buffer_load_dwordx4 v3, s[24:27], s62 offen offset:1024 nt lds
    s_barrier
    s_mov_b32 m0, s95
    s_waitcnt vmcnt(4)
    buffer_load_dwordx4 v3, s[24:27], s63 offen offset:1024 nt lds
    ds_read_b128 v[32:35], v64
    ds_read_b128 v[36:39], v65
    ds_read_b128 v[40:43], v66
    ds_read_b128 v[44:47], v67
    ds_read_b128 v[48:51], v68
    ds_read_b128 v[52:55], v69
    ds_read_b128 v[56:59], v70
    ds_read_b128 v[60:63], v71
    v_mov_b32 v11, 0x5028965f
    v_lshlrev_b32 v96, 16, v112
    v_and_b32 v97, 0xffff0000, v112
    v_lshlrev_b32 v98, 16, v113
    v_and_b32 v99, 0xffff0000, v113
    v_lshlrev_b32 v100, 16, v114
    v_and_b32 v101, 0xffff0000, v114
    v_lshlrev_b32 v102, 16, v115
    v_and_b32 v103, 0xffff0000, v115
    v_fma_f32 v96, v96, v11, -v11
    v_fma_f32 v97, v97, v11, -v11
    v_fma_f32 v98, v98, v11, -v11
    v_fma_f32 v99, v99, v11, -v11
    v_fma_f32 v100, v100, v11, -v11
    v_fma_f32 v101, v101, v11, -v11
    v_fma_f32 v102, v102, v11, -v11
    v_fma_f32 v103, v103, v11, -v11
    v_mov_b32 v104, 0
    v_mov_b32 v105, 0
    v_mov_b32 v106, 0
    v_mov_b32 v107, 0
    v_mov_b32 v108, 0
    v_mov_b32 v109, 0
    v_mov_b32 v110, 0
    v_mov_b32 v111, 0
    s_waitcnt lgkmcnt(0)
    s_mov_b32 m0, s94
    s_waitcnt vmcnt(4)
    buffer_load_dwordx4 v4, s[24:27], s62 offen offset:2048 nt lds
    ds_read_b128 v[64:67], v16 offset:16384
    ds_read_b128 v[68:71], v17 offset:16384
    ds_read_b128 v[72:75], v18 offset:16384
    ds_read_b128 v[76:79], v19 offset:16384
    ds_read_b128 v[80:83], v20 offset:16384
    ds_read_b128 v[84:87], v21 offset:16384
    ds_read_b128 v[88:91], v22 offset:16384
    ds_read_b128 v[92:95], v23 offset:16384
    s_waitcnt lgkmcnt(6)
    v_mfma_f32_32x32x16_bf16 v[96:111], v[64:67], v[32:35], v[96:111]
    v_mfma_f32_32x32x16_bf16 v[96:111], v[68:71], v[36:39], v[96:111]
    s_mov_b32 m0, s95
    s_waitcnt vmcnt(4)
    buffer_load_dwordx4 v4, s[24:27], s63 offen offset:2048 nt lds
    s_waitcnt lgkmcnt(4)
    v_mfma_f32_32x32x16_bf16 v[96:111], v[72:75], v[40:43], v[96:111]
    v_mfma_f32_32x32x16_bf16 v[96:111], v[76:79], v[44:47], v[96:111]
    s_waitcnt lgkmcnt(2)
    v_mfma_f32_32x32x16_bf16 v[96:111], v[80:83], v[48:51], v[96:111]
    v_mfma_f32_32x32x16_bf16 v[96:111], v[84:87], v[52:55], v[96:111]
    s_waitcnt lgkmcnt(0)
    v_mfma_f32_32x32x16_bf16 v[96:111], v[88:91], v[56:59], v[96:111]
    s_mov_b32 m0, s94
    s_waitcnt vmcnt(4)
    buffer_load_dwordx4 v5, s[24:27], s62 offen offset:3072 nt lds
    v_mfma_f32_32x32x16_bf16 v[96:111], v[92:95], v[60:63], v[96:111]
    s_nop 7
    s_nop 3
    v_max3_f32 v11, v96, v97, v98
    v_max3_f32 v12, v99, v100, v101
    v_max3_f32 v11, v102, v103, v11
    v_max_f32 v11, v11, v12
    v_mov_b32 v12, v11
    s_nop 1
    v_permlane32_swap_b32 v11, v12
    v_max_f32 v11, v11, v12
    v_mul_f32 v11, s65, v11
    v_ceil_f32 v11, v11
    v_max_f32 v11, v11, v9
    v_sub_f32 v12, v9, v11
    v_mov_b32 v9, v11
    v_exp_f32 v10, v12
    s_mov_b32 m0, s95
    s_waitcnt vmcnt(4)
    buffer_load_dwordx4 v5, s[24:27], s63 offen offset:3072 nt lds
    v_add_f32 v240, 0x41000000, v11
    v_mul_f32 v240, 0x40faf233, v240
    v_mul_f32 v8, v8, v10
    v_fma_f32 v96, v96, s65, -v9
    v_fma_f32 v97, v97, s65, -v9
    v_fma_f32 v98, v98, s65, -v9
    v_fma_f32 v99, v99, s65, -v9
    v_fma_f32 v100, v100, s65, -v9
    v_fma_f32 v101, v101, s65, -v9
    v_fma_f32 v102, v102, s65, -v9
    v_fma_f32 v103, v103, s65, -v9
    v_exp_f32 v96, v96
    v_exp_f32 v97, v97
    v_exp_f32 v98, v98
    v_exp_f32 v99, v99
    v_exp_f32 v100, v100
    v_exp_f32 v101, v101
    v_exp_f32 v102, v102
    v_exp_f32 v103, v103
    v_cvt_pk_bf16_f32 v112, v96, v97
    v_cvt_pk_bf16_f32 v113, v98, v99
    v_cvt_pk_bf16_f32 v114, v100, v101
    v_cvt_pk_bf16_f32 v115, v102, v103
    v_dot2c_f32_bf16 v8, s73, v112
    v_dot2c_f32_bf16 v8, s73, v113
    v_dot2c_f32_bf16 v8, s73, v114
    v_dot2c_f32_bf16 v8, s73, v115
    v_mov_b32 v152, v112
    v_mov_b32 v153, v113
    v_mov_b32 v154, v114
    v_mov_b32 v155, v115
    v_mov_b32 v156, v9
    s_branch L_main
L_oscale:
    v_sub_f32 v11, v11, v157
    v_exp_f32 v11, v11
    s_nop 0
    v_mul_f32 v200, v11, v200
    v_mul_f32 v201, v11, v201
    v_mul_f32 v202, v11, v202
    v_mul_f32 v203, v11, v203
    v_mul_f32 v204, v11, v204
    v_mul_f32 v205, v11, v205
    v_mul_f32 v206, v11, v206
    v_mul_f32 v207, v11, v207
    v_mul_f32 v208, v11, v208
    v_mul_f32 v209, v11, v209
    v_mul_f32 v210, v11, v210
    v_mul_f32 v211, v11, v211
    v_mul_f32 v212, v11, v212
    v_mul_f32 v213, v11, v213
    v_mul_f32 v214, v11, v214
    v_mul_f32 v215, v11, v215
    s_branch L_vloop
L_ckA28b:
    v_sub_f32 v104, v160, v157
    v_sub_f32 v105, v162, v157
    v_sub_f32 v106, v164, v157
    v_sub_f32 v107, v166, v157
    v_exp_f32 v104, v104
    v_exp_f32 v105, v105
    v_exp_f32 v106, v106
    v_exp_f32 v107, v107
    v_mul_f32 v158, v104, v161
    v_fmac_f32 v158, v105, v163
    v_fmac_f32 v158, v106, v165
    v_fmac_f32 v158, v107, v167
    v_max_f32 v11, v157, v232
    v_sub_f32 v246, v157, v11
    v_sub_f32 v247, v232, v11
    v_exp_f32 v247, v247
    v_exp_f32 v246, v246
    v_mul_f32 v247, v247, v233
    v_fma_f32 v11, v246, v158, v247
    v_rcp_f32 v11, v11
    s_nop 0
    v_mul_f32 v246, v246, v11
    v_mul_f32 v247, v247, v11
    s_branch L_ckA_ret
L_solo:
    s_cmp_eq_u32 s72, 0
    s_cbranch_scc1 L_done
    s_cmp_eq_u32 s74, 1
    s_cbranch_scc1 L_scale
    s_mov_b32 s74, 1
    s_waitcnt vmcnt(0) lgkmcnt(0)
    s_barrier
    s_mov_b32 s3, 0
    s_xor_b32 s67, s67, 1
    v_xor_b32 v24, 16384, v24
    v_xor_b32 v25, 16384, v25
    v_mov_b32 v232, 0xf149f2ca
    v_mov_b32 v233, 0
    v_mov_b32 v216, 0
    v_mov_b32 v217, 0
    v_mov_b32 v218, 0
    v_mov_b32 v219, 0
    v_mov_b32 v220, 0
    v_mov_b32 v221, 0
    v_mov_b32 v222, 0
    v_mov_b32 v223, 0
    s_lshl_b32 s68, s66, 21
    s_add_u32 s24, s8, s68
    s_addc_u32 s25, s9, 0
    s_and_b32 s25, s25, 0xffff
    s_lshl_b32 s62, s67, 2
    s_add_u32 s62, s62, s60
    s_lshl_b32 s62, s62, 12
    s_add_u32 s63, s62, 65536
    v_xor_b32 v2, 0, v7
    v_xor_b32 v3, 64, v7
    v_xor_b32 v4, 128, v7
    v_xor_b32 v5, 192, v7
    s_add_u32 m0, s61, 0
    s_nop 0
    buffer_load_dwordx4 v2, s[24:27], s62 offen offset:0 nt lds
    s_add_u32 m0, s61, 4096
    s_nop 0
    buffer_load_dwordx4 v2, s[24:27], s63 offen offset:0 nt lds
    s_add_u32 m0, s61, 0
    s_nop 0
    buffer_load_dwordx4 v3, s[24:27], s62 offen offset:1024 nt lds
    s_add_u32 m0, s61, 4096
    s_nop 0
    buffer_load_dwordx4 v3, s[24:27], s63 offen offset:1024 nt lds
    s_add_u32 m0, s61, 0
    s_nop 0
    buffer_load_dwordx4 v4, s[24:27], s62 offen offset:2048 nt lds
    s_add_u32 m0, s61, 4096
    s_nop 0
    buffer_load_dwordx4 v4, s[24:27], s63 offen offset:2048 nt lds
    s_add_u32 m0, s61, 0
    s_nop 0
    buffer_load_dwordx4 v5, s[24:27], s62 offen offset:3072 nt lds
    s_add_u32 m0, s61, 4096
    s_nop 0
    buffer_load_dwordx4 v5, s[24:27], s63 offen offset:3072 nt lds
    s_add_u32 s62, s62, 32768
    s_add_u32 s63, s63, 32768
    s_add_u32 m0, s61, 8192
    s_nop 0
    buffer_load_dwordx4 v2, s[24:27], s62 offen offset:0 nt lds
    s_add_u32 m0, s61, 12288
    s_nop 0
    buffer_load_dwordx4 v2, s[24:27], s63 offen offset:0 nt lds
    s_add_u32 m0, s61, 8192
    s_nop 0
    buffer_load_dwordx4 v3, s[24:27], s62 offen offset:1024 nt lds
    s_add_u32 m0, s61, 12288
    s_nop 0
    buffer_load_dwordx4 v3, s[24:27], s63 offen offset:1024 nt lds
    s_add_u32 m0, s61, 8192
    s_nop 0
    buffer_load_dwordx4 v4, s[24:27], s62 offen offset:2048 nt lds
    s_add_u32 m0, s61, 12288
    s_nop 0
    buffer_load_dwordx4 v4, s[24:27], s63 offen offset:2048 nt lds
    s_add_u32 m0, s61, 8192
    s_nop 0
    buffer_load_dwordx4 v5, s[24:27], s62 offen offset:3072 nt lds
    s_add_u32 m0, s61, 12288
    s_nop 0
    buffer_load_dwordx4 v5, s[24:27], s63 offen offset:3072 nt lds
    s_branch L_main
L_code_end:
.section .rodata,"a"
.p2align 6
.amdhsa_kernel standalone__tree_speculative_verify_tree_attention_over_candidate_token_tree__sampling_kernel
  .amdhsa_next_free_vgpr 504
  .amdhsa_next_free_sgpr 102
  .amdhsa_accum_offset 248
  .amdhsa_group_segment_fixed_size 0
  .amdhsa_kernarg_size 72
  .amdhsa_user_sgpr_count 2
  .amdhsa_user_sgpr_kernarg_segment_ptr 1
  .amdhsa_system_sgpr_workgroup_id_x 1
.end_amdhsa_kernel
```
